```python
import torch

def _softmax(x, axis=-1):
    return torch.softmax(x, dim=axis)
def _gelu(x):
    return torch.nn.functional.gelu(x, approximate="tanh")
def _silu(x):
    return torch.nn.functional.silu(x)
def _sigmoid(x):
    return torch.sigmoid(x)
def _layernorm(x, axis=-1, eps=1e-5):
    m = x.mean(dim=axis, keepdim=True)
    v = x.var(dim=axis, keepdim=True, unbiased=False)
    return (x - m) / torch.sqrt(v + eps)
def _scatter_add(tgt, idx, src, axis=0):
    return tgt.clone().index_add_(axis, idx, src)
def _segment_sum(src, seg, n):
    out = torch.zeros((n,) + src.shape[1:], dtype=src.dtype)
    return out.index_add_(0, seg, src)
def _pad(x, pw):
    flat = tuple(v for pair in reversed(pw) for v in pair)
    return torch.nn.functional.pad(x, flat)

kernel_name = 'standalone__mha_softmax__sampling'

def setup_inputs():

    _w = (lambda a: (lambda t: t.to(torch.bfloat16) if t.is_floating_point() else t)(torch.as_tensor(a)))
    B, H, Sq, Sk, D = 16, 32, 1, 2048, 128
    return {
        "q": _w((lambda *s: torch.randn(*s, dtype=torch.bfloat16) * 0.8)(B, H, Sq, D)),
        "k": _w((lambda *s: torch.randn(*s, dtype=torch.bfloat16) * 0.8)(B, H, Sk, D)),
        "v": _w((lambda *s: torch.randn(*s, dtype=torch.bfloat16) * 0.05)(B, H, Sk, D)),
    }

def reference(q, k, v):
    scale = q.shape[-1] ** -0.5
    scores = torch.einsum("bhqd,bhkd->bhqk", q, k) * scale
    p = _softmax(scores, axis=-1)
    return torch.einsum("bhqk,bhkd->bhqd", p, v)
```

```asm
; @launch grid=(256,1,1) block=(320,1,1) lds=82944
.amdgcn_target "amdgcn-amd-amdhsa--gfx950"
.text
.globl standalone__mha_softmax__sampling_kernel
.p2align 8
.type standalone__mha_softmax__sampling_kernel,@function
standalone__mha_softmax__sampling_kernel:
    s_load_dwordx4 s[4:7], s[0:1], 0
    v_lshrrev_b32 v4, 6, v0
    v_and_b32 v5, 63, v0
    v_readfirstlane_b32 s3, v4
    v_lshlrev_b32 v1, 4, v5
    v_lshl_add_u32 v1, v4, 12, v1
    s_bfe_u32 s54, s2, 0x10000
    s_lshl_b32 s54, s54, 14
    s_lshl_b32 s50, s2, 20
    s_lshr_b32 s62, s2, 8
    s_cbranch_scc1 L_end
    s_lshl_b32 s14, 1, 20
    s_mov_b32 s15, 0x00020000
    s_waitcnt lgkmcnt(0)
    s_add_u32 s12, s6, s50
    s_addc_u32 s13, s7, 0
    s_and_b32 s13, s13, 0xffff
    s_cmp_eq_u32 s3, 4
    s_cbranch_scc1 L_control
    buffer_load_dwordx4 v[72:75], v1, s[12:15], s54 offen offset:0 nt
    buffer_load_dwordx4 v[76:79], v1, s[12:15], s54 offen offset:1024 nt
    buffer_load_dwordx4 v[80:83], v1, s[12:15], s54 offen offset:2048 nt
    buffer_load_dwordx4 v[84:87], v1, s[12:15], s54 offen offset:3072 nt
    s_add_u32 s52, s54, 32768
    buffer_load_dwordx4 v[88:91], v1, s[12:15], s52 offen offset:0 nt
    buffer_load_dwordx4 v[92:95], v1, s[12:15], s52 offen offset:1024 nt
    buffer_load_dwordx4 v[96:99], v1, s[12:15], s52 offen offset:2048 nt
    buffer_load_dwordx4 v[100:103], v1, s[12:15], s52 offen offset:3072 nt
    s_load_dwordx4 s[8:11], s[0:1], 16
    v_and_b32 v2, 15, v0
    v_lshlrev_b32 v2, 4, v2
    s_lshl_b32 s51, s2, 9
    s_mov_b32 s22, 512
    s_mov_b32 s23, 0x00020000
    s_mov_b32 s55, 256
    s_add_u32 s20, s4, s51
    s_addc_u32 s21, s5, 0
    s_and_b32 s21, s21, 0xffff
    buffer_load_dwordx4 v[40:43], v2, s[20:23], 0 offen
    buffer_load_dwordx4 v[44:47], v2, s[20:23], s55 offen
    s_mov_b32 s33, 0x3e0293ee
    s_mov_b32 s34, 0xffff0000
    v_lshlrev_b32 v3, 3, v5
    v_and_b32 v6, 1, v0
    v_lshlrev_b32 v6, 4, v6
    v_mov_b32 v7, 0xffff
    v_lshlrev_b32 v7, v6, v7
    v_bfe_u32 v6, v0, 1, 3
    v_cmp_eq_u32 vcc, 0, v6
    s_nop 1
    v_cndmask_b32 v12, 0, v7, vcc
    v_cmp_eq_u32 vcc, 1, v6
    s_nop 1
    v_cndmask_b32 v13, 0, v7, vcc
    v_cmp_eq_u32 vcc, 2, v6
    s_nop 1
    v_cndmask_b32 v14, 0, v7, vcc
    v_cmp_eq_u32 vcc, 3, v6
    s_nop 1
    v_cndmask_b32 v15, 0, v7, vcc
    v_lshrrev_b32 v6, 4, v5
    v_lshlrev_b32 v6, 4, v6
    v_lshl_add_u32 v51, v2, 1, v6
    v_lshlrev_b32 v37, 2, v5
    v_lshlrev_b32 v38, 2, v5
    v_lshl_add_u32 v38, v4, 14, v38
    v_mov_b32 v27, 1
    v_mov_b32 v36, 65536
    v_mov_b32 v16, 0xff800000
    s_mov_b32 s46, 0
    s_mov_b32 s45, 8
    s_waitcnt lgkmcnt(0)
    s_add_u32 s16, s8, s50
    s_addc_u32 s17, s9, 0
    s_and_b32 s17, s17, 0xffff
    s_add_u32 s24, s10, s51
    s_addc_u32 s25, s11, 0
    s_and_b32 s25, s25, 0xffff
    s_mov_b32 s26, 512
    s_mov_b32 s27, 0x00020000
    s_add_u32 s52, s54, 65536
    s_waitcnt vmcnt(7)
    buffer_load_dwordx4 v[104:107], v1, s[12:15], s52 offen offset:0 nt
    s_waitcnt vmcnt(7)
    buffer_load_dwordx4 v[108:111], v1, s[12:15], s52 offen offset:1024 nt
    s_waitcnt vmcnt(7)
    buffer_load_dwordx4 v[112:115], v1, s[12:15], s52 offen offset:2048 nt
    s_waitcnt vmcnt(7)
    buffer_load_dwordx4 v[116:119], v1, s[12:15], s52 offen offset:3072 nt
    s_add_u32 s52, s54, 98304
    s_waitcnt vmcnt(7)
    buffer_load_dwordx4 v[120:123], v1, s[12:15], s52 offen offset:0 nt
    s_waitcnt vmcnt(7)
    buffer_load_dwordx4 v[124:127], v1, s[12:15], s52 offen offset:1024 nt
    s_waitcnt vmcnt(7)
    buffer_load_dwordx4 v[128:131], v1, s[12:15], s52 offen offset:2048 nt
    s_waitcnt vmcnt(7)
    buffer_load_dwordx4 v[132:135], v1, s[12:15], s52 offen offset:3072 nt
    s_mov_b32 s44, 65536
    s_barrier
    s_waitcnt vmcnt(8)
L_kloop:
    s_cmp_lt_u32 s44, 1048576
    s_cbranch_scc1 L_kgo
    s_mov_b32 s12, s16
    s_mov_b32 s13, s17
    s_mov_b32 s44, 0
L_kgo:
    s_and_b32 s53, s44, 0x180000
    s_bfe_u32 s62, s44, 0x10010
    s_lshl_b32 s62, s62, 17
    s_or_b32 s53, s53, s62
    s_bfe_u32 s62, s44, 0x10011
    s_lshl_b32 s62, s62, 18
    s_or_b32 s53, s53, s62
    s_bfe_u32 s62, s44, 0x10012
    s_lshl_b32 s62, s62, 14
    s_or_b32 s53, s53, s62
    s_xor_b32 s53, s53, s54
    s_mov_b64 exec, 1
    ds_add_u32 v36, v27 offset:4368
    s_mov_b64 exec, -1
    ds_read_b32 v50, v36 offset:4372
    s_add_u32 s52, s53, 0
    s_waitcnt vmcnt(12)
    v_dot2_f32_bf16 v18, v72, v40, 0
    v_dot2_f32_bf16 v19, v76, v40, 0
    v_dot2_f32_bf16 v20, v80, v40, 0
    v_dot2_f32_bf16 v21, v84, v40, 0
    v_dot2_f32_bf16 v18, v73, v41, v18
    v_dot2_f32_bf16 v19, v77, v41, v19
    v_dot2_f32_bf16 v20, v81, v41, v20
    v_dot2_f32_bf16 v21, v85, v41, v21
    v_dot2_f32_bf16 v18, v74, v42, v18
    v_dot2_f32_bf16 v19, v78, v42, v19
    v_dot2_f32_bf16 v20, v82, v42, v20
    v_dot2_f32_bf16 v21, v86, v42, v21
    v_dot2_f32_bf16 v18, v75, v43, v18
    v_dot2_f32_bf16 v19, v79, v43, v19
    v_dot2_f32_bf16 v20, v83, v43, v20
    v_dot2_f32_bf16 v21, v87, v43, v21
    s_waitcnt lgkmcnt(0)
    v_cmp_ne_u32 vcc, 0, v50
    s_cbranch_vccnz L_w8
    s_waitcnt vmcnt(4)
L_w8:
    s_waitcnt vmcnt(7)
    buffer_load_dwordx4 v[72:75], v1, s[12:15], s52 offen offset:0 nt
    v_add_f32_dpp v18, v18, v18 row_ror:8 row_mask:0xf bank_mask:0x3
    v_add_f32_dpp v20, v20, v20 row_ror:8 row_mask:0xf bank_mask:0x3
    s_nop 0
    v_add_f32_dpp v18, v19, v19 row_ror:8 row_mask:0xf bank_mask:0xc
    v_add_f32_dpp v20, v21, v21 row_ror:8 row_mask:0xf bank_mask:0xc
    s_cbranch_vccnz L_w9
    s_waitcnt vmcnt(4)
L_w9:
    s_waitcnt vmcnt(7)
    buffer_load_dwordx4 v[76:79], v1, s[12:15], s52 offen offset:1024 nt
    v_add_f32_dpp v22, v18, v18 row_ror:12 row_mask:0xf bank_mask:0x5
    s_nop 1
    v_add_f32_dpp v22, v20, v20 row_ror:4 row_mask:0xf bank_mask:0xa
    s_cbranch_vccnz L_w10
    s_waitcnt vmcnt(4)
L_w10:
    s_waitcnt vmcnt(7)
    buffer_load_dwordx4 v[80:83], v1, s[12:15], s52 offen offset:2048 nt
    v_add_f32_dpp v22, v22, v22 quad_perm:[1,0,3,2] row_mask:0xf bank_mask:0xf
    s_cbranch_vccnz L_w11
    s_waitcnt vmcnt(4)
L_w11:
    s_waitcnt vmcnt(7)
    buffer_load_dwordx4 v[84:87], v1, s[12:15], s52 offen offset:3072 nt
    v_add_f32_dpp v22, v22, v22 quad_perm:[2,3,0,1] row_mask:0xf bank_mask:0xf
    s_add_u32 s44, s44, 16384
    ds_write_b32 v38, v22 offset:0
    v_max_f32 v16, v16, v22
    s_mov_b64 exec, 1
    ds_add_u32 v36, v27 offset:4368
    s_mov_b64 exec, -1
    s_add_u32 s52, s53, 32768
    s_waitcnt vmcnt(12)
    v_dot2_f32_bf16 v18, v88, v40, 0
    v_dot2_f32_bf16 v19, v92, v40, 0
    v_dot2_f32_bf16 v20, v96, v40, 0
    v_dot2_f32_bf16 v21, v100, v40, 0
    v_dot2_f32_bf16 v18, v89, v41, v18
    v_dot2_f32_bf16 v19, v93, v41, v19
    v_dot2_f32_bf16 v20, v97, v41, v20
    v_dot2_f32_bf16 v21, v101, v41, v21
    v_dot2_f32_bf16 v18, v90, v42, v18
    v_dot2_f32_bf16 v19, v94, v42, v19
    v_dot2_f32_bf16 v20, v98, v42, v20
    v_dot2_f32_bf16 v21, v102, v42, v21
    v_dot2_f32_bf16 v18, v91, v43, v18
    v_dot2_f32_bf16 v19, v95, v43, v19
    v_dot2_f32_bf16 v20, v99, v43, v20
    v_dot2_f32_bf16 v21, v103, v43, v21
    s_cbranch_vccnz L_w12
    s_waitcnt vmcnt(4)
L_w12:
    s_waitcnt vmcnt(7)
    buffer_load_dwordx4 v[88:91], v1, s[12:15], s52 offen offset:0 nt
    v_add_f32_dpp v18, v18, v18 row_ror:8 row_mask:0xf bank_mask:0x3
    v_add_f32_dpp v20, v20, v20 row_ror:8 row_mask:0xf bank_mask:0x3
    s_nop 0
    v_add_f32_dpp v18, v19, v19 row_ror:8 row_mask:0xf bank_mask:0xc
    v_add_f32_dpp v20, v21, v21 row_ror:8 row_mask:0xf bank_mask:0xc
    s_cbranch_vccnz L_w13
    s_waitcnt vmcnt(4)
L_w13:
    s_waitcnt vmcnt(7)
    buffer_load_dwordx4 v[92:95], v1, s[12:15], s52 offen offset:1024 nt
    v_add_f32_dpp v22, v18, v18 row_ror:12 row_mask:0xf bank_mask:0x5
    s_nop 1
    v_add_f32_dpp v22, v20, v20 row_ror:4 row_mask:0xf bank_mask:0xa
    s_cbranch_vccnz L_w14
    s_waitcnt vmcnt(4)
L_w14:
    s_waitcnt vmcnt(7)
    buffer_load_dwordx4 v[96:99], v1, s[12:15], s52 offen offset:2048 nt
    v_add_f32_dpp v22, v22, v22 quad_perm:[1,0,3,2] row_mask:0xf bank_mask:0xf
    s_cbranch_vccnz L_w15
    s_waitcnt vmcnt(4)
L_w15:
    s_waitcnt vmcnt(7)
    buffer_load_dwordx4 v[100:103], v1, s[12:15], s52 offen offset:3072 nt
    v_add_f32_dpp v22, v22, v22 quad_perm:[2,3,0,1] row_mask:0xf bank_mask:0xf
    s_add_u32 s44, s44, 16384
    ds_write_b32 v38, v22 offset:256
    v_max_f32 v16, v16, v22
    s_mov_b64 exec, 1
    ds_add_u32 v36, v27 offset:4368
    s_mov_b64 exec, -1
    ds_read_b32 v50, v36 offset:4372
    s_add_u32 s52, s53, 65536
    s_waitcnt vmcnt(12)
    v_dot2_f32_bf16 v18, v104, v40, 0
    v_dot2_f32_bf16 v19, v108, v40, 0
    v_dot2_f32_bf16 v20, v112, v40, 0
    v_dot2_f32_bf16 v21, v116, v40, 0
    v_dot2_f32_bf16 v18, v105, v41, v18
    v_dot2_f32_bf16 v19, v109, v41, v19
    v_dot2_f32_bf16 v20, v113, v41, v20
    v_dot2_f32_bf16 v21, v117, v41, v21
    v_dot2_f32_bf16 v18, v106, v42, v18
    v_dot2_f32_bf16 v19, v110, v42, v19
    v_dot2_f32_bf16 v20, v114, v42, v20
    v_dot2_f32_bf16 v21, v118, v42, v21
    v_dot2_f32_bf16 v18, v107, v43, v18
    v_dot2_f32_bf16 v19, v111, v43, v19
    v_dot2_f32_bf16 v20, v115, v43, v20
    v_dot2_f32_bf16 v21, v119, v43, v21
    s_waitcnt lgkmcnt(0)
    v_cmp_ne_u32 vcc, 0, v50
    s_cbranch_vccnz L_w16
    s_waitcnt vmcnt(4)
L_w16:
    s_waitcnt vmcnt(7)
    buffer_load_dwordx4 v[104:107], v1, s[12:15], s52 offen offset:0 nt
    v_add_f32_dpp v18, v18, v18 row_ror:8 row_mask:0xf bank_mask:0x3
    v_add_f32_dpp v20, v20, v20 row_ror:8 row_mask:0xf bank_mask:0x3
    s_nop 0
    v_add_f32_dpp v18, v19, v19 row_ror:8 row_mask:0xf bank_mask:0xc
    v_add_f32_dpp v20, v21, v21 row_ror:8 row_mask:0xf bank_mask:0xc
    s_cbranch_vccnz L_w17
    s_waitcnt vmcnt(4)
L_w17:
    s_waitcnt vmcnt(7)
    buffer_load_dwordx4 v[108:111], v1, s[12:15], s52 offen offset:1024 nt
    v_add_f32_dpp v22, v18, v18 row_ror:12 row_mask:0xf bank_mask:0x5
    s_nop 1
    v_add_f32_dpp v22, v20, v20 row_ror:4 row_mask:0xf bank_mask:0xa
    s_cbranch_vccnz L_w18
    s_waitcnt vmcnt(4)
L_w18:
    s_waitcnt vmcnt(7)
    buffer_load_dwordx4 v[112:115], v1, s[12:15], s52 offen offset:2048 nt
    v_add_f32_dpp v22, v22, v22 quad_perm:[1,0,3,2] row_mask:0xf bank_mask:0xf
    s_cbranch_vccnz L_w19
    s_waitcnt vmcnt(4)
L_w19:
    s_waitcnt vmcnt(7)
    buffer_load_dwordx4 v[116:119], v1, s[12:15], s52 offen offset:3072 nt
    v_add_f32_dpp v22, v22, v22 quad_perm:[2,3,0,1] row_mask:0xf bank_mask:0xf
    s_add_u32 s44, s44, 16384
    ds_write_b32 v38, v22 offset:512
    v_max_f32 v16, v16, v22
    s_mov_b64 exec, 1
    ds_add_u32 v36, v27 offset:4368
    s_mov_b64 exec, -1
    s_add_u32 s52, s53, 98304
    s_waitcnt vmcnt(12)
    v_dot2_f32_bf16 v18, v120, v40, 0
    v_dot2_f32_bf16 v19, v124, v40, 0
    v_dot2_f32_bf16 v20, v128, v40, 0
    v_dot2_f32_bf16 v21, v132, v40, 0
    v_dot2_f32_bf16 v18, v121, v41, v18
    v_dot2_f32_bf16 v19, v125, v41, v19
    v_dot2_f32_bf16 v20, v129, v41, v20
    v_dot2_f32_bf16 v21, v133, v41, v21
    v_dot2_f32_bf16 v18, v122, v42, v18
    v_dot2_f32_bf16 v19, v126, v42, v19
    v_dot2_f32_bf16 v20, v130, v42, v20
    v_dot2_f32_bf16 v21, v134, v42, v21
    v_dot2_f32_bf16 v18, v123, v43, v18
    v_dot2_f32_bf16 v19, v127, v43, v19
    v_dot2_f32_bf16 v20, v131, v43, v20
    v_dot2_f32_bf16 v21, v135, v43, v21
    s_cbranch_vccnz L_w20
    s_waitcnt vmcnt(4)
L_w20:
    s_waitcnt vmcnt(7)
    buffer_load_dwordx4 v[120:123], v1, s[12:15], s52 offen offset:0 nt
    v_add_f32_dpp v18, v18, v18 row_ror:8 row_mask:0xf bank_mask:0x3
    v_add_f32_dpp v20, v20, v20 row_ror:8 row_mask:0xf bank_mask:0x3
    s_nop 0
    v_add_f32_dpp v18, v19, v19 row_ror:8 row_mask:0xf bank_mask:0xc
    v_add_f32_dpp v20, v21, v21 row_ror:8 row_mask:0xf bank_mask:0xc
    s_cbranch_vccnz L_w21
    s_waitcnt vmcnt(4)
L_w21:
    s_waitcnt vmcnt(7)
    buffer_load_dwordx4 v[124:127], v1, s[12:15], s52 offen offset:1024 nt
    v_add_f32_dpp v22, v18, v18 row_ror:12 row_mask:0xf bank_mask:0x5
    s_nop 1
    v_add_f32_dpp v22, v20, v20 row_ror:4 row_mask:0xf bank_mask:0xa
    s_cbranch_vccnz L_w22
    s_waitcnt vmcnt(4)
L_w22:
    s_waitcnt vmcnt(7)
    buffer_load_dwordx4 v[128:131], v1, s[12:15], s52 offen offset:2048 nt
    v_add_f32_dpp v22, v22, v22 quad_perm:[1,0,3,2] row_mask:0xf bank_mask:0xf
    s_cbranch_vccnz L_w23
    s_waitcnt vmcnt(4)
L_w23:
    s_waitcnt vmcnt(7)
    buffer_load_dwordx4 v[132:135], v1, s[12:15], s52 offen offset:3072 nt
    v_add_f32_dpp v22, v22, v22 quad_perm:[2,3,0,1] row_mask:0xf bank_mask:0xf
    s_add_u32 s44, s44, 16384
    ds_write_b32 v38, v22 offset:768
    v_max_f32 v16, v16, v22
    v_add_u32 v38, 1024, v38
    s_sub_u32 s45, s45, 1
    s_cmp_lg_u32 s45, 0
    s_cbranch_scc1 L_kloop
    v_max_f32_dpp v16, v16, v16 row_ror:4 row_mask:0xf bank_mask:0xf
    s_mov_b32 s45, 8
    s_nop 0
    v_max_f32_dpp v16, v16, v16 row_ror:8 row_mask:0xf bank_mask:0xf
    v_mov_b32 v23, v16
    s_nop 1
    v_permlane32_swap_b32 v23, v16
    s_nop 1
    v_max_f32 v16, v23, v16
    v_mov_b32 v23, v16
    s_nop 1
    v_permlane16_swap_b32 v23, v16
    s_nop 1
    v_max_f32 v16, v23, v16
    v_mul_f32 v49, s33, v16
    s_cmp_lg_u32 s46, 0
    s_cbranch_scc1 L_vstart
    s_mov_b32 s46, 1
    v_mov_b32 v48, v49
    v_mov_b32 v16, 0xff800000
    v_mov_b32 v40, v44
    v_mov_b32 v41, v45
    v_mov_b32 v42, v46
    v_mov_b32 v43, v47
    s_branch L_kloop
L_vstart:
    s_mov_b32 s59, 1048576
    v_subrev_u32 v38, 16384, v38
    s_mov_b32 s46, 0
    ds_read_b32 v52, v38
L_vhead:
    v_sub_f32 v39, 0, v48
    v_mov_b32 v8, 0
    v_mov_b32 v9, 0
    v_mov_b32 v10, 0
    v_mov_b32 v11, 0
    v_mov_b32 v17, 0
L_vloop:
    s_cmp_ge_u32 s44, 983040
    s_cselect_b32 s56, -1, 0
    s_and_b32 s53, s44, 0x180000
    s_bfe_u32 s62, s44, 0x10010
    s_lshl_b32 s62, s62, 17
    s_or_b32 s53, s53, s62
    s_bfe_u32 s62, s44, 0x10011
    s_lshl_b32 s62, s62, 18
    s_or_b32 s53, s53, s62
    s_bfe_u32 s62, s44, 0x10012
    s_lshl_b32 s62, s62, 14
    s_or_b32 s53, s53, s62
    s_xor_b32 s53, s53, s54
    s_waitcnt lgkmcnt(0)
    v_cmp_ne_u32 vcc, s56, v50
    v_fma_f32 v26, v52, s33, v39
    s_mov_b64 exec, 1
    ds_add_u32 v36, v27 offset:4368
    s_mov_b64 exec, -1
    ds_read_b32 v53, v38 offset:256
    ds_read_b32 v50, v36 offset:4372
    v_exp_f32 v26, v26
    s_add_u32 s52, s53, 0
    v_cvt_pk_bf16_f32 v25, v26, v26
    v_and_b32 v26, s34, v25
    v_add_f32 v17, v17, v26
    v_and_b32_dpp v28, v25, v12 row_newbcast:0 row_mask:0xf bank_mask:0xf
    v_and_b32_dpp v29, v25, v13 row_newbcast:0 row_mask:0xf bank_mask:0xf
    v_and_b32_dpp v30, v25, v14 row_newbcast:0 row_mask:0xf bank_mask:0xf
    v_and_b32_dpp v31, v25, v15 row_newbcast:0 row_mask:0xf bank_mask:0xf
    s_waitcnt vmcnt(15)
    s_nop 0
    v_mfma_f32_16x16x32_bf16 v[8:11], v[28:31], v[72:75], v[8:11]
    s_cbranch_vccz L_n24
    s_cmp_ge_u32 s44, s59
    s_cbranch_scc1 L_w24
    s_waitcnt vmcnt(7)
    s_branch L_w24
L_n24:
    s_waitcnt vmcnt(4)
L_w24:
    buffer_load_dwordx4 v[72:75], v1, s[12:15], s52 offen offset:0 nt
    v_and_b32_dpp v32, v25, v12 row_newbcast:8 row_mask:0xf bank_mask:0xf
    v_and_b32_dpp v33, v25, v13 row_newbcast:8 row_mask:0xf bank_mask:0xf
    v_and_b32_dpp v34, v25, v14 row_newbcast:8 row_mask:0xf bank_mask:0xf
    v_and_b32_dpp v35, v25, v15 row_newbcast:8 row_mask:0xf bank_mask:0xf
    s_waitcnt vmcnt(15)
    s_nop 0
    v_mfma_f32_16x16x32_bf16 v[8:11], v[32:35], v[76:79], v[8:11]
    s_cbranch_vccz L_n25
    s_cmp_ge_u32 s44, s59
    s_cbranch_scc1 L_w25
    s_waitcnt vmcnt(7)
    s_branch L_w25
L_n25:
    s_waitcnt vmcnt(4)
L_w25:
    buffer_load_dwordx4 v[76:79], v1, s[12:15], s52 offen offset:1024 nt
    v_and_b32_dpp v28, v25, v12 row_newbcast:4 row_mask:0xf bank_mask:0xf
    v_and_b32_dpp v29, v25, v13 row_newbcast:4 row_mask:0xf bank_mask:0xf
    v_and_b32_dpp v30, v25, v14 row_newbcast:4 row_mask:0xf bank_mask:0xf
    v_and_b32_dpp v31, v25, v15 row_newbcast:4 row_mask:0xf bank_mask:0xf
    s_waitcnt vmcnt(15)
    s_nop 0
    v_mfma_f32_16x16x32_bf16 v[8:11], v[28:31], v[80:83], v[8:11]
    s_cbranch_vccz L_n26
    s_cmp_ge_u32 s44, s59
    s_cbranch_scc1 L_w26
    s_waitcnt vmcnt(7)
    s_branch L_w26
L_n26:
    s_waitcnt vmcnt(4)
L_w26:
    buffer_load_dwordx4 v[80:83], v1, s[12:15], s52 offen offset:2048 nt
    v_and_b32_dpp v32, v25, v12 row_newbcast:12 row_mask:0xf bank_mask:0xf
    v_and_b32_dpp v33, v25, v13 row_newbcast:12 row_mask:0xf bank_mask:0xf
    v_and_b32_dpp v34, v25, v14 row_newbcast:12 row_mask:0xf bank_mask:0xf
    v_and_b32_dpp v35, v25, v15 row_newbcast:12 row_mask:0xf bank_mask:0xf
    s_waitcnt vmcnt(15)
    s_nop 0
    v_mfma_f32_16x16x32_bf16 v[8:11], v[32:35], v[84:87], v[8:11]
    s_cbranch_vccz L_n27
    s_cmp_ge_u32 s44, s59
    s_cbranch_scc1 L_w27
    s_waitcnt vmcnt(7)
    s_branch L_w27
L_n27:
    s_waitcnt vmcnt(4)
L_w27:
    buffer_load_dwordx4 v[84:87], v1, s[12:15], s52 offen offset:3072 nt
    s_add_u32 s44, s44, 16384
    s_waitcnt lgkmcnt(0)
    v_cmp_ne_u32 vcc, s56, v50
    v_fma_f32 v26, v53, s33, v39
    s_mov_b64 exec, 1
    ds_add_u32 v36, v27 offset:4368
    s_mov_b64 exec, -1
    ds_read_b32 v54, v38 offset:512
    v_exp_f32 v26, v26
    s_add_u32 s52, s53, 32768
    v_cvt_pk_bf16_f32 v25, v26, v26
    v_and_b32 v26, s34, v25
    v_add_f32 v17, v17, v26
    v_and_b32_dpp v28, v25, v12 row_newbcast:0 row_mask:0xf bank_mask:0xf
    v_and_b32_dpp v29, v25, v13 row_newbcast:0 row_mask:0xf bank_mask:0xf
    v_and_b32_dpp v30, v25, v14 row_newbcast:0 row_mask:0xf bank_mask:0xf
    v_and_b32_dpp v31, v25, v15 row_newbcast:0 row_mask:0xf bank_mask:0xf
    s_waitcnt vmcnt(15)
    s_nop 0
    v_mfma_f32_16x16x32_bf16 v[8:11], v[28:31], v[88:91], v[8:11]
    s_cbranch_vccz L_n28
    s_cmp_ge_u32 s44, s59
    s_cbranch_scc1 L_w28
    s_waitcnt vmcnt(7)
    s_branch L_w28
L_n28:
    s_waitcnt vmcnt(4)
L_w28:
    buffer_load_dwordx4 v[88:91], v1, s[12:15], s52 offen offset:0 nt
    v_and_b32_dpp v32, v25, v12 row_newbcast:8 row_mask:0xf bank_mask:0xf
    v_and_b32_dpp v33, v25, v13 row_newbcast:8 row_mask:0xf bank_mask:0xf
    v_and_b32_dpp v34, v25, v14 row_newbcast:8 row_mask:0xf bank_mask:0xf
    v_and_b32_dpp v35, v25, v15 row_newbcast:8 row_mask:0xf bank_mask:0xf
    s_waitcnt vmcnt(15)
    s_nop 0
    v_mfma_f32_16x16x32_bf16 v[8:11], v[32:35], v[92:95], v[8:11]
    s_cbranch_vccz L_n29
    s_cmp_ge_u32 s44, s59
    s_cbranch_scc1 L_w29
    s_waitcnt vmcnt(7)
    s_branch L_w29
L_n29:
    s_waitcnt vmcnt(4)
L_w29:
    buffer_load_dwordx4 v[92:95], v1, s[12:15], s52 offen offset:1024 nt
    v_and_b32_dpp v28, v25, v12 row_newbcast:4 row_mask:0xf bank_mask:0xf
    v_and_b32_dpp v29, v25, v13 row_newbcast:4 row_mask:0xf bank_mask:0xf
    v_and_b32_dpp v30, v25, v14 row_newbcast:4 row_mask:0xf bank_mask:0xf
    v_and_b32_dpp v31, v25, v15 row_newbcast:4 row_mask:0xf bank_mask:0xf
    s_waitcnt vmcnt(15)
    s_nop 0
    v_mfma_f32_16x16x32_bf16 v[8:11], v[28:31], v[96:99], v[8:11]
    s_cbranch_vccz L_n30
    s_cmp_ge_u32 s44, s59
    s_cbranch_scc1 L_w30
    s_waitcnt vmcnt(7)
    s_branch L_w30
L_n30:
    s_waitcnt vmcnt(4)
L_w30:
    buffer_load_dwordx4 v[96:99], v1, s[12:15], s52 offen offset:2048 nt
    v_and_b32_dpp v32, v25, v12 row_newbcast:12 row_mask:0xf bank_mask:0xf
    v_and_b32_dpp v33, v25, v13 row_newbcast:12 row_mask:0xf bank_mask:0xf
    v_and_b32_dpp v34, v25, v14 row_newbcast:12 row_mask:0xf bank_mask:0xf
    v_and_b32_dpp v35, v25, v15 row_newbcast:12 row_mask:0xf bank_mask:0xf
    s_waitcnt vmcnt(15)
    s_nop 0
    v_mfma_f32_16x16x32_bf16 v[8:11], v[32:35], v[100:103], v[8:11]
    s_cbranch_vccz L_n31
    s_cmp_ge_u32 s44, s59
    s_cbranch_scc1 L_w31
    s_waitcnt vmcnt(7)
    s_branch L_w31
L_n31:
    s_waitcnt vmcnt(4)
L_w31:
    buffer_load_dwordx4 v[100:103], v1, s[12:15], s52 offen offset:3072 nt
    s_add_u32 s44, s44, 16384
    s_waitcnt lgkmcnt(0)
    v_cmp_ne_u32 vcc, s56, v50
    v_fma_f32 v26, v54, s33, v39
    s_mov_b64 exec, 1
    ds_add_u32 v36, v27 offset:4368
    s_mov_b64 exec, -1
    ds_read_b32 v55, v38 offset:768
    ds_read_b32 v50, v36 offset:4372
    v_exp_f32 v26, v26
    s_add_u32 s52, s53, 65536
    v_cvt_pk_bf16_f32 v25, v26, v26
    v_and_b32 v26, s34, v25
    v_add_f32 v17, v17, v26
    v_and_b32_dpp v28, v25, v12 row_newbcast:0 row_mask:0xf bank_mask:0xf
    v_and_b32_dpp v29, v25, v13 row_newbcast:0 row_mask:0xf bank_mask:0xf
    v_and_b32_dpp v30, v25, v14 row_newbcast:0 row_mask:0xf bank_mask:0xf
    v_and_b32_dpp v31, v25, v15 row_newbcast:0 row_mask:0xf bank_mask:0xf
    s_waitcnt vmcnt(15)
    s_nop 0
    v_mfma_f32_16x16x32_bf16 v[8:11], v[28:31], v[104:107], v[8:11]
    s_cbranch_vccz L_n32
    s_cmp_ge_u32 s44, s59
    s_cbranch_scc1 L_w32
    s_waitcnt vmcnt(7)
    s_branch L_w32
L_n32:
    s_waitcnt vmcnt(4)
L_w32:
    buffer_load_dwordx4 v[104:107], v1, s[12:15], s52 offen offset:0 nt
    v_and_b32_dpp v32, v25, v12 row_newbcast:8 row_mask:0xf bank_mask:0xf
    v_and_b32_dpp v33, v25, v13 row_newbcast:8 row_mask:0xf bank_mask:0xf
    v_and_b32_dpp v34, v25, v14 row_newbcast:8 row_mask:0xf bank_mask:0xf
    v_and_b32_dpp v35, v25, v15 row_newbcast:8 row_mask:0xf bank_mask:0xf
    s_waitcnt vmcnt(15)
    s_nop 0
    v_mfma_f32_16x16x32_bf16 v[8:11], v[32:35], v[108:111], v[8:11]
    s_cbranch_vccz L_n33
    s_cmp_ge_u32 s44, s59
    s_cbranch_scc1 L_w33
    s_waitcnt vmcnt(7)
    s_branch L_w33
L_n33:
    s_waitcnt vmcnt(4)
L_w33:
    buffer_load_dwordx4 v[108:111], v1, s[12:15], s52 offen offset:1024 nt
    v_and_b32_dpp v28, v25, v12 row_newbcast:4 row_mask:0xf bank_mask:0xf
    v_and_b32_dpp v29, v25, v13 row_newbcast:4 row_mask:0xf bank_mask:0xf
    v_and_b32_dpp v30, v25, v14 row_newbcast:4 row_mask:0xf bank_mask:0xf
    v_and_b32_dpp v31, v25, v15 row_newbcast:4 row_mask:0xf bank_mask:0xf
    s_waitcnt vmcnt(15)
    s_nop 0
    v_mfma_f32_16x16x32_bf16 v[8:11], v[28:31], v[112:115], v[8:11]
    s_cbranch_vccz L_n34
    s_cmp_ge_u32 s44, s59
    s_cbranch_scc1 L_w34
    s_waitcnt vmcnt(7)
    s_branch L_w34
L_n34:
    s_waitcnt vmcnt(4)
L_w34:
    buffer_load_dwordx4 v[112:115], v1, s[12:15], s52 offen offset:2048 nt
    v_and_b32_dpp v32, v25, v12 row_newbcast:12 row_mask:0xf bank_mask:0xf
    v_and_b32_dpp v33, v25, v13 row_newbcast:12 row_mask:0xf bank_mask:0xf
    v_and_b32_dpp v34, v25, v14 row_newbcast:12 row_mask:0xf bank_mask:0xf
    v_and_b32_dpp v35, v25, v15 row_newbcast:12 row_mask:0xf bank_mask:0xf
    s_waitcnt vmcnt(15)
    s_nop 0
    v_mfma_f32_16x16x32_bf16 v[8:11], v[32:35], v[116:119], v[8:11]
    s_cbranch_vccz L_n35
    s_cmp_ge_u32 s44, s59
    s_cbranch_scc1 L_w35
    s_waitcnt vmcnt(7)
    s_branch L_w35
L_n35:
    s_waitcnt vmcnt(4)
L_w35:
    buffer_load_dwordx4 v[116:119], v1, s[12:15], s52 offen offset:3072 nt
    s_add_u32 s44, s44, 16384
    s_waitcnt lgkmcnt(0)
    v_cmp_ne_u32 vcc, s56, v50
    v_fma_f32 v26, v55, s33, v39
    s_mov_b64 exec, 1
    ds_add_u32 v36, v27 offset:4368
    s_mov_b64 exec, -1
    ds_read_b32 v52, v38 offset:1024
    v_exp_f32 v26, v26
    s_add_u32 s52, s53, 98304
    v_cvt_pk_bf16_f32 v25, v26, v26
    v_and_b32 v26, s34, v25
    v_add_f32 v17, v17, v26
    v_and_b32_dpp v28, v25, v12 row_newbcast:0 row_mask:0xf bank_mask:0xf
    v_and_b32_dpp v29, v25, v13 row_newbcast:0 row_mask:0xf bank_mask:0xf
    v_and_b32_dpp v30, v25, v14 row_newbcast:0 row_mask:0xf bank_mask:0xf
    v_and_b32_dpp v31, v25, v15 row_newbcast:0 row_mask:0xf bank_mask:0xf
    s_waitcnt vmcnt(15)
    s_nop 0
    v_mfma_f32_16x16x32_bf16 v[8:11], v[28:31], v[120:123], v[8:11]
    s_cbranch_vccz L_n36
    s_cmp_ge_u32 s44, s59
    s_cbranch_scc1 L_w36
    s_waitcnt vmcnt(7)
    s_branch L_w36
L_n36:
    s_waitcnt vmcnt(4)
L_w36:
    buffer_load_dwordx4 v[120:123], v1, s[12:15], s52 offen offset:0 nt
    v_and_b32_dpp v32, v25, v12 row_newbcast:8 row_mask:0xf bank_mask:0xf
    v_and_b32_dpp v33, v25, v13 row_newbcast:8 row_mask:0xf bank_mask:0xf
    v_and_b32_dpp v34, v25, v14 row_newbcast:8 row_mask:0xf bank_mask:0xf
    v_and_b32_dpp v35, v25, v15 row_newbcast:8 row_mask:0xf bank_mask:0xf
    s_waitcnt vmcnt(15)
    s_nop 0
    v_mfma_f32_16x16x32_bf16 v[8:11], v[32:35], v[124:127], v[8:11]
    s_cbranch_vccz L_n37
    s_cmp_ge_u32 s44, s59
    s_cbranch_scc1 L_w37
    s_waitcnt vmcnt(7)
    s_branch L_w37
L_n37:
    s_waitcnt vmcnt(4)
L_w37:
    buffer_load_dwordx4 v[124:127], v1, s[12:15], s52 offen offset:1024 nt
    v_and_b32_dpp v28, v25, v12 row_newbcast:4 row_mask:0xf bank_mask:0xf
    v_and_b32_dpp v29, v25, v13 row_newbcast:4 row_mask:0xf bank_mask:0xf
    v_and_b32_dpp v30, v25, v14 row_newbcast:4 row_mask:0xf bank_mask:0xf
    v_and_b32_dpp v31, v25, v15 row_newbcast:4 row_mask:0xf bank_mask:0xf
    s_waitcnt vmcnt(15)
    s_nop 0
    v_mfma_f32_16x16x32_bf16 v[8:11], v[28:31], v[128:131], v[8:11]
    s_cbranch_vccz L_n38
    s_cmp_ge_u32 s44, s59
    s_cbranch_scc1 L_w38
    s_waitcnt vmcnt(7)
    s_branch L_w38
L_n38:
    s_waitcnt vmcnt(4)
L_w38:
    buffer_load_dwordx4 v[128:131], v1, s[12:15], s52 offen offset:2048 nt
    v_and_b32_dpp v32, v25, v12 row_newbcast:12 row_mask:0xf bank_mask:0xf
    v_and_b32_dpp v33, v25, v13 row_newbcast:12 row_mask:0xf bank_mask:0xf
    v_and_b32_dpp v34, v25, v14 row_newbcast:12 row_mask:0xf bank_mask:0xf
    v_and_b32_dpp v35, v25, v15 row_newbcast:12 row_mask:0xf bank_mask:0xf
    s_waitcnt vmcnt(15)
    s_nop 0
    v_mfma_f32_16x16x32_bf16 v[8:11], v[32:35], v[132:135], v[8:11]
    s_cbranch_vccz L_n39
    s_cmp_ge_u32 s44, s59
    s_cbranch_scc1 L_w39
    s_waitcnt vmcnt(7)
    s_branch L_w39
L_n39:
    s_waitcnt vmcnt(4)
L_w39:
    buffer_load_dwordx4 v[132:135], v1, s[12:15], s52 offen offset:3072 nt
    s_add_u32 s44, s44, 16384
    v_add_u32 v38, 1024, v38
    s_sub_u32 s45, s45, 1
    s_cmp_lg_u32 s45, 0
    s_cbranch_scc1 L_vloop
    s_mul_i32 s63, s46, 2176
    s_add_u32 s63, s63, 65536
    v_add_f32_dpp v17, v17, v17 row_ror:4 row_mask:0xf bank_mask:0xf
    s_lshl_b32 s64, s3, 9
    s_add_u32 s64, s64, s63
    v_add_f32_dpp v17, v17, v17 row_ror:8 row_mask:0xf bank_mask:0xf
    v_add_u32 v4, s64, v51
    v_mov_b32 v23, v17
    s_mov_b32 exec_hi, 0
    ds_write_b128 v4, v[8:11]
    s_mov_b32 exec_hi, -1
    v_permlane32_swap_b32 v17, v23
    s_lshl_b32 s64, s3, 3
    s_add_u32 s64, s64, s63
    v_add_f32 v17, v17, v23
    v_mov_b32 v23, v17
    v_mov_b32 v5, s64
    v_mov_b32 v24, v48
    v_permlane16_swap_b32 v17, v23
    s_lshl_b32 s65, s46, 2
    v_add_u32 v6, s65, v36
    v_add_f32 v25, v17, v23
    ds_write_b64 v5, v[24:25] offset:2048
    s_waitcnt lgkmcnt(0)
    s_mov_b64 exec, 1
    ds_add_rtn_u32 v7, v6, v27 offset:4352
    s_mov_b64 exec, -1
    v_add_u32 v4, s63, v3
    v_mov_b32 v5, s63
    s_waitcnt lgkmcnt(0)
    v_readfirstlane_b32 s66, v7
    s_cmp_lg_u32 s66, 3
    s_cbranch_scc1 L_head_ret
    ds_read_b128 v[56:59], v5 offset:2048
    ds_read_b128 v[60:63], v5 offset:2064
    ds_read_b64 v[64:65], v4 offset:0
    ds_read_b64 v[66:67], v4 offset:512
    ds_read_b64 v[68:69], v4 offset:1024
    ds_read_b64 v[70:71], v4 offset:1536
    s_waitcnt lgkmcnt(4)
    v_max_f32 v24, v56, v58
    v_max3_f32 v24, v24, v60, v62
    v_sub_f32 v56, v56, v24
    v_sub_f32 v58, v58, v24
    v_sub_f32 v60, v60, v24
    v_sub_f32 v62, v62, v24
    v_exp_f32 v56, v56
    v_exp_f32 v58, v58
    v_exp_f32 v60, v60
    v_exp_f32 v62, v62
    s_mul_i32 s64, s46, s55
    v_mul_f32 v17, v56, v57
    v_fmac_f32 v17, v58, v59
    v_fmac_f32 v17, v60, v61
    v_fmac_f32 v17, v62, v63
    v_rcp_f32 v23, v17
    s_waitcnt lgkmcnt(0)
    v_mul_f32 v18, v56, v64
    v_mul_f32 v19, v56, v65
    v_fmac_f32 v18, v58, v66
    v_fmac_f32 v19, v58, v67
    v_fmac_f32 v18, v60, v68
    v_fmac_f32 v19, v60, v69
    v_fmac_f32 v18, v62, v70
    v_fmac_f32 v19, v62, v71
    v_mul_f32 v18, v18, v23
    v_mul_f32 v19, v19, v23
    v_cvt_pk_bf16_f32 v7, v18, v19
    buffer_store_dword v7, v37, s[24:27], s64 offen
L_head_ret:
    s_cmp_lg_u32 s46, 0
    s_cbranch_scc1 L_end
    s_mov_b32 s46, 1
    s_mov_b32 s45, 8
    v_mov_b32 v48, v49
    s_branch L_vhead
L_control:
    s_load_dwordx2 s[36:37], s[0:1], 32
    v_mov_b32 v36, 65536
    v_mov_b32 v8, 0
    v_mov_b32 v9, 0
    v_mov_b32 v10, 0
    v_mov_b32 v11, 0
    ds_write_b128 v36, v[8:11] offset:4352
    ds_write_b128 v36, v[8:11] offset:4368
    v_lshlrev_b32 v12, 2, v5
    s_lshr_b32 s60, s2, 3
    s_lshl_b32 s60, s60, 2
    s_mov_b32 s42, 128
    s_mov_b32 s43, 0x00020000
    s_waitcnt lgkmcnt(0)
    s_mov_b32 s40, s36
    s_and_b32 s41, s37, 0xffff
    s_barrier
L_poll:
    s_sleep 32
    ds_read_b32 v10, v36 offset:4368
    buffer_load_dword v9, v12, s[40:43], 0 offen sc0
    s_waitcnt lgkmcnt(0)
    s_mov_b64 exec, 1
    buffer_store_dword v10, v8, s[40:43], s60 offen
    s_mov_b64 exec, -1
    v_add_u32 v11, 4, v10
    v_readfirstlane_b32 s62, v10
    s_waitcnt vmcnt(1)
    v_cmp_gt_u32 vcc, v9, v11
    v_cmp_ne_u32 s[64:65], 0, v9
    s_bcnt1_i32_b64 s66, vcc
    s_bcnt1_i32_b64 s67, s[64:65]
    s_lshl_b32 s66, s66, 4
    s_mul_i32 s67, s67, 5
    s_cmp_gt_u32 s66, s67
    s_cselect_b32 s66, 1, 0
    v_mov_b32 v11, s66
    ds_write_b32 v36, v11 offset:4372
    s_cmp_lt_u32 s62, 380
    s_cbranch_scc1 L_poll
L_poll2:
    s_sleep 8
    ds_read_b32 v10, v36 offset:4368
    buffer_load_dword v9, v12, s[40:43], 0 offen sc0
    s_waitcnt lgkmcnt(0)
    s_mov_b64 exec, 1
    buffer_store_dword v10, v8, s[40:43], s60 offen
    s_mov_b64 exec, -1
    v_add_u32 v11, 0, v10
    v_readfirstlane_b32 s62, v10
    s_waitcnt vmcnt(1)
    v_cmp_gt_u32 vcc, v9, v11
    v_cmp_ne_u32 s[64:65], 0, v9
    s_bcnt1_i32_b64 s66, vcc
    s_bcnt1_i32_b64 s67, s[64:65]
    s_lshl_b32 s66, s66, 4
    s_mul_i32 s67, s67, 5
    s_cmp_gt_u32 s66, s67
    s_cselect_b32 s66, 1, 0
    v_mov_b32 v11, s66
    ds_write_b32 v36, v11 offset:4372
    s_cmp_lt_u32 s62, 472
    s_cbranch_scc1 L_poll2
L_end:
    s_endpgm
.section .rodata,"a"
.p2align 6
.amdhsa_kernel standalone__mha_softmax__sampling_kernel
  .amdhsa_next_free_vgpr 136
  .amdhsa_next_free_sgpr 80
  .amdhsa_accum_offset 136
  .amdhsa_group_segment_fixed_size 0
  .amdhsa_kernarg_size 48
  .amdhsa_user_sgpr_count 2
  .amdhsa_user_sgpr_kernarg_segment_ptr 1
  .amdhsa_system_sgpr_workgroup_id_x 1
  .amdhsa_float_denorm_mode_32 3
.end_amdhsa_kernel
```
